```python
import torch

def _softmax(x, axis=-1):
    return torch.softmax(x, dim=axis)
def _gelu(x):
    return torch.nn.functional.gelu(x, approximate="tanh")
def _silu(x):
    return torch.nn.functional.silu(x)
def _sigmoid(x):
    return torch.sigmoid(x)
def _layernorm(x, axis=-1, eps=1e-5):
    m = x.mean(dim=axis, keepdim=True)
    v = x.var(dim=axis, keepdim=True, unbiased=False)
    return (x - m) / torch.sqrt(v + eps)
def _scatter_add(tgt, idx, src, axis=0):
    return tgt.clone().index_add_(axis, idx, src)
def _segment_sum(src, seg, n):
    out = torch.zeros((n,) + src.shape[1:], dtype=src.dtype)
    return out.index_add_(0, seg, src)
def _pad(x, pw):
    flat = tuple(v for pair in reversed(pw) for v in pair)
    return torch.nn.functional.pad(x, flat)

kernel_name = 'gather_scatter__kernel_systems_refs_featgraph__graph'

def setup_inputs():

    _w = (lambda a: (lambda t: t.to(torch.bfloat16) if t.is_floating_point() else t)(torch.as_tensor(a)))
    N, deg, D = 50000, 16, 64
    E = N * deg
    scale = D ** -0.5
    src = (lambda lo, hi, *s: torch.randint(lo, hi, s))(0, N, E).to(torch.int64)
    dst = (lambda lo, hi, *s: torch.randint(lo, hi, s))(0, N, E).to(torch.int64)
    return {
        "x": _w((lambda *s: torch.randn(*s, dtype=torch.bfloat16) * 0.8)(N, D)),
        "src": _w(src),
        "dst": _w(dst),
        "w_q": _w((lambda *s: torch.randn(*s, dtype=torch.bfloat16) * 0.8)(D, D) * scale),
        "w_v": _w((lambda *s: torch.randn(*s, dtype=torch.bfloat16) * 0.05)(D, D) * scale),
    }

def reference(x, src, dst, w_q, w_v):
    N, D = x.shape
    xs = x[src]
    xd = x[dst]
    q = xd @ w_q
    logits = torch.einsum('ed,ed->e', xs, q) * (float(D) ** -0.5)
    alpha = _sigmoid(logits)
    msg = alpha[:, None] * (xs @ w_v)
    return _segment_sum(msg, dst, N)
```

```asm
; @launch grid=(241,1,1) block=(832,1,1) lds=150528
.amdgcn_target "amdgcn-amd-amdhsa--gfx950"
.text
.globl gather_scatter__kernel_systems_refs_featgraph__graph_kernel
.p2align 8
.type gather_scatter__kernel_systems_refs_featgraph__graph_kernel,@function
gather_scatter__kernel_systems_refs_featgraph__graph_kernel:
    s_load_dwordx16 s[44:59], s[0:1], 0
    s_cmp_ge_u32 s2, 241
    s_cbranch_scc1 K_END
    v_lshrrev_b32 v15, 6, v0
    v_and_b32 v1, 63, v0
    v_readfirstlane_b32 s64, v15
    v_lshlrev_b32 v72, 4, v0
    s_mul_i32 s75, s2, 13312
    s_mul_i32 s65, s2, 208
    v_mov_b32 v104, -1
    v_mov_b32 v105, -1
    v_mov_b32 v106, -1
    v_mov_b32 v107, -1
    s_mov_b32 s74, 15728640
    s_mov_b32 s19, -2
    s_waitcnt lgkmcnt(0)
    s_mov_b32 s8, s48
    s_and_b32 s9, s49, 0xffff
    s_mov_b32 s10, 3200000
    s_mov_b32 s11, 0x00020000
    buffer_load_dwordx4 v[92:95], v72, s[8:11], s75 offen
    s_mov_b32 s4, s46
    s_and_b32 s5, s47, 0xffff
    s_mov_b32 s6, 3200000
    s_mov_b32 s7, 0x00020000
    buffer_load_dwordx4 v[88:91], v72, s[4:7], s75 offen
    s_mov_b32 s24, s58
    s_and_b32 s25, s59, 0xffff
    s_mov_b32 s26, 16777216
    s_mov_b32 s27, 0x00020000
    v_mov_b32 v74, 0
    buffer_load_dword v74, v74, s[24:27], s74 offen sc1
    ds_write_b128 v72, v[104:107]
    ds_write_b128 v72, v[104:107] offset:13312
    ds_write_b128 v72, v[104:107] offset:39936
    v_cmp_gt_u32 vcc, 64, v0
    v_subrev_u32 v79, 328, v0
    v_mov_b32 v123, 4
    v_cndmask_b32_e64 v108, v104, 0, vcc
    v_cmp_gt_u32 vcc, 64, v79
    v_mov_b32 v109, v108
    v_mov_b32 v110, v108
    v_mov_b32 v111, v108
    ds_write_b128 v72, v[108:111] offset:26624
    v_cndmask_b32_e64 v112, v104, 0, vcc
    v_cmp_gt_u32 vcc, 65, v79
    v_mov_b32 v114, v112
    v_mov_b32 v115, v112
    v_cndmask_b32_e64 v113, v104, 0, vcc
    ds_write_b128 v72, v[112:115] offset:53248
    s_cmp_lt_u32 s64, 2
    s_cselect_b32 s50, s50, s52
    s_cselect_b32 s51, s51, s53
    s_mov_b32 s28, s50
    s_and_b32 s29, s51, 0xffff
    s_mov_b32 s30, 8192
    s_mov_b32 s31, 0x00020000
    s_mov_b32 s20, s44
    s_and_b32 s21, s45, 0xffff
    s_mov_b32 s22, 6400000
    s_mov_b32 s23, 0x00020000
    s_mov_b32 s36, s54
    s_and_b32 s37, s55, 0xffff
    s_mov_b32 s38, 6400000
    s_mov_b32 s39, 0x00020000
    s_mov_b32 s12, s58
    s_and_b32 s13, s59, 0xffff
    s_mov_b32 s14, 7434368
    s_mov_b32 s15, 0x00020000
    v_mov_b32 v116, 59520
    v_mov_b32 v117, 31868
    s_mul_i32 s75, s2, 832
    v_add_u32 v79, s75, v0
    v_lshlrev_b32 v75, 4, v1
    v_and_b32 v76, 15, v1
    v_lshrrev_b32 v77, 4, v1
    s_lshl_b32 s74, s64, 4
    v_add_u32 v14, s74, v76
    s_add_u32 s74, s74, s65
    s_lshl_b32 s18, s74, 7
    s_lshl_b32 s83, s64, 11
    s_lshl_b32 s74, s64, 10
    v_cmp_gt_u32 vcc, 200000, v79
    s_add_u32 m0, s83, 72864
    s_waitcnt lgkmcnt(0)
    s_barrier
    buffer_load_dwordx4 v75, s[20:23], s18 offen lds
    buffer_load_dwordx4 v75, s[20:23], s18 offen offset:1024 lds
    s_cmp_ge_u32 s64, 4
    s_cbranch_scc1 K_NOW
    s_lshl_b32 s74, s64, 12
    s_add_u32 m0, s74, 134144
    s_and_b32 s74, s74, 4096
    buffer_load_dwordx4 v75, s[28:31], s74 offen offset:0 lds
    buffer_load_dwordx4 v75, s[28:31], s74 offen offset:1024 lds
    buffer_load_dwordx4 v75, s[28:31], s74 offen offset:2048 lds
    buffer_load_dwordx4 v75, s[28:31], s74 offen offset:3072 lds
K_NOW:
    s_mov_b64 s[80:81], vcc
    s_mov_b32 s69, 128
    s_mov_b32 s76, 512
    s_mov_b32 s79, 0xbe38aa3b
    s_mov_b32 s82, 0x40000000
    s_lshl_b32 s70, s64, 13
    s_add_u32 s70, s70, 27648
    s_lshl_b32 s75, s64, 11
    v_and_b32 v79, 3, v76
    v_lshrrev_b32 v80, 2, v76
    v_lshl_add_u32 v81, v77, 3, v80
    v_lshlrev_b32 v81, 7, v81
    v_lshl_add_u32 v124, v79, 5, v81
    v_lshl_add_u32 v81, v77, 2, v80
    v_lshlrev_b32 v81, 7, v81
    v_lshl_add_u32 v125, v79, 5, v81
    v_add_u32 v124, 134144, v124
    v_add_u32 v125, 142336, v125
    v_lshl_add_u32 v81, v76, 7, s75
    v_lshl_add_u32 v81, v77, 4, v81
    v_add_u32 v81, 72864, v81
    v_mov_b32 v84, v81
    v_lshrrev_b32 v82, 3, v1
    v_lshl_add_u32 v8, v82, 4, s75
    v_lshl_add_u32 v9, v76, 2, s75
    v_lshl_add_u32 v78, v1, 2, s75
    v_and_b32 v82, 7, v1
    v_and_b32 v83, 1, v77
    v_xor_b32 v82, v82, v83
    v_lshlrev_b32 v10, 4, v82
    v_xor_b32 v11, 32, v10
    v_xor_b32 v12, 64, v10
    v_xor_b32 v13, 96, v10
    v_lshl_add_u32 v81, v79, 3, v80
    v_lshrrev_b32 v82, 3, v76
    v_lshl_add_u32 v82, v79, 1, v82
    v_lshlrev_b32 v83, 1, v77
    v_xor_b32 v82, v82, v83
    v_lshl_add_u32 v82, v82, 4, s70
    v_lshl_add_u32 v2, v81, 7, v82
    v_xor_b32 v3, 16, v2
    v_lshl_add_u32 v81, v80, 3, v77
    v_lshrrev_b32 v82, 1, v79
    v_lshrrev_b32 v83, 1, v77
    v_xor_b32 v82, v82, v83
    v_lshl_add_u32 v82, v80, 1, v82
    v_lshl_add_u32 v82, v82, 4, s70
    v_lshl_add_u32 v82, v81, 7, v82
    v_and_b32 v83, 1, v79
    v_lshl_add_u32 v4, v83, 3, v82
    v_xor_b32 v5, 32, v4
    v_xor_b32 v6, 64, v4
    v_xor_b32 v7, 96, v4
    s_mul_i32 s78, s2, 30848
    v_add_u32 v85, s78, v72
    v_add_u32 v85, 26624, v85
    v_add_u32 v86, 8384384, v72
    v_cmp_gt_u32 vcc, 264, v0
    v_mov_b32 v126, s2
    s_nop 0
    v_cndmask_b32 v85, v86, v85, vcc
    s_mov_b64 s[84:85], vcc
    v_cmp_gt_u32 vcc, 746, v0
    v_lshlrev_b32 v87, 4, v76
    s_mov_b64 s[86:87], vcc
    s_cmp_lt_u32 s64, 4
    s_cbranch_scc1 K_NOW2
    s_waitcnt vmcnt(2)
K_NOW2:
    s_waitcnt vmcnt(6)
    s_mov_b64 exec, s[80:81]
    s_cbranch_execz K_BINDONE
    s_movk_i32 s75, 0xff30
    v_mul_u32_u24 v96, 80660, v92
    v_lshrrev_b32 v96, 24, v96
    v_lshlrev_b32 v100, 2, v96
    ds_add_rtn_u32 v104, v100, v123 offset:58496
    v_mul_u32_u24 v97, 80660, v93
    v_lshrrev_b32 v97, 24, v97
    v_lshlrev_b32 v101, 2, v97
    ds_add_rtn_u32 v105, v101, v123 offset:58496
    v_mul_u32_u24 v98, 80660, v94
    v_lshrrev_b32 v98, 24, v98
    v_lshlrev_b32 v102, 2, v98
    ds_add_rtn_u32 v106, v102, v123 offset:58496
    v_mul_u32_u24 v99, 80660, v95
    v_lshrrev_b32 v99, 24, v99
    v_lshlrev_b32 v103, 2, v99
    ds_add_rtn_u32 v107, v103, v123 offset:58496
    v_mad_i32_i24 v92, v96, s75, v92
    v_lshl_or_b32 v92, v96, 8, v92
    v_lshl_or_b32 v88, v92, 16, v88
    v_mad_i32_i24 v93, v97, s75, v93
    v_lshl_or_b32 v93, v97, 8, v93
    v_lshl_or_b32 v89, v93, 16, v89
    v_mad_i32_i24 v94, v98, s75, v94
    v_lshl_or_b32 v94, v98, 8, v94
    v_lshl_or_b32 v90, v94, 16, v90
    v_mad_i32_i24 v95, v99, s75, v95
    v_lshl_or_b32 v95, v99, 8, v95
    v_lshl_or_b32 v91, v95, 16, v91
    s_waitcnt lgkmcnt(3)
    v_cmp_gt_u32 vcc, 128, v104
    v_lshl_add_u32 v100, v96, 7, v104
    s_nop 0
    v_cndmask_b32 v100, v117, v100, vcc
    ds_write_b32 v100, v88 offset:27648
    s_waitcnt lgkmcnt(3)
    v_cmp_gt_u32 vcc, 128, v105
    v_lshl_add_u32 v101, v97, 7, v105
    s_nop 0
    v_cndmask_b32 v101, v117, v101, vcc
    ds_write_b32 v101, v89 offset:27648
    s_waitcnt lgkmcnt(3)
    v_cmp_gt_u32 vcc, 128, v106
    v_lshl_add_u32 v102, v98, 7, v106
    s_nop 0
    v_cndmask_b32 v102, v117, v102, vcc
    ds_write_b32 v102, v90 offset:27648
    s_waitcnt lgkmcnt(3)
    v_cmp_gt_u32 vcc, 128, v107
    v_lshl_add_u32 v103, v99, 7, v107
    s_nop 0
    v_cndmask_b32 v103, v117, v103, vcc
    ds_write_b32 v103, v91 offset:27648
    v_max3_u32 v108, v104, v105, v106
    v_max_u32 v108, v108, v107
    v_cmp_le_u32 vcc, 128, v108
    s_cbranch_vccnz K_OVF
K_BINDONE:
    s_mov_b64 exec, -1
    v_lshrrev_b32 v118, 3, v0
    v_mul_u32_u24 v118, 30848, v118
    v_and_b32 v119, 7, v0
    v_lshl_add_u32 v118, v119, 4, v118
    s_lshl_b32 s75, s2, 7
    s_add_u32 s74, s75, 3208192
    s_add_u32 s83, s75, 6416384
    v_readfirstlane_b32 s3, v74
    s_add_u32 s3, s3, 1
    s_mul_i32 s16, s3, 0x9E3779B1
    s_mov_b32 s17, 0x00ffffff
    v_mov_b32 v111, s16
    v_lshlrev_b32 v108, 24, v111
    v_lshlrev_b32 v109, 16, v111
    v_lshlrev_b32 v110, 8, v111
    s_waitcnt lgkmcnt(0)
    s_barrier
    ds_read_b128 v[88:91], v72 offset:27648
    ds_read_b128 v[92:95], v72 offset:40960
    v_add_u32 v73, 54272, v72
    ds_read_b128 v[96:99], v73
    ds_read_b32 v104, v116 offset:4
    ds_read_b128 v[100:103], v75 offset:59520
    s_waitcnt lgkmcnt(4)
    v_cmp_ne_u32 vcc, -1, v91
    v_bfi_b32 v88, s17, v88, v108
    v_bfi_b32 v89, s17, v89, v109
    v_bfi_b32 v90, s17, v90, v110
    v_bfi_b32 v91, s17, v91, v111
    s_and_b32 s46, vcc_lo, 0x08080808
    s_mul_i32 s46, s46, 30
    s_or_b32 exec_lo, s46, 0x0f0f0f0f
    s_and_b32 s46, vcc_hi, 0x08080808
    s_mul_i32 s46, s46, 30
    s_or_b32 exec_hi, s46, 0x0f0f0f0f
    buffer_store_dwordx4 v[88:91], v118, s[12:15], s75 offen sc1
    s_mov_b64 exec, -1
    s_waitcnt lgkmcnt(3)
    v_cmp_ne_u32 vcc, -1, v95
    v_bfi_b32 v92, s17, v92, v108
    v_bfi_b32 v93, s17, v93, v109
    v_bfi_b32 v94, s17, v94, v110
    v_bfi_b32 v95, s17, v95, v111
    s_and_b32 s46, vcc_lo, 0x08080808
    s_mul_i32 s46, s46, 30
    s_or_b32 exec_lo, s46, 0x0f0f0f0f
    s_and_b32 s46, vcc_hi, 0x08080808
    s_mul_i32 s46, s46, 30
    s_or_b32 exec_hi, s46, 0x0f0f0f0f
    buffer_store_dwordx4 v[92:95], v118, s[12:15], s74 offen sc1
    s_mov_b64 exec, -1
    s_waitcnt lgkmcnt(2)
    v_cmp_ne_u32 vcc, -1, v99
    v_bfi_b32 v96, s17, v96, v108
    v_bfi_b32 v97, s17, v97, v109
    v_bfi_b32 v98, s17, v98, v110
    v_bfi_b32 v99, s17, v99, v111
    s_and_b32 s46, vcc_lo, 0x08080808
    s_mul_i32 s46, s46, 30
    s_or_b32 exec_lo, s46, 0x0f0f0f0f
    s_and_b32 s46, vcc_hi, 0x08080808
    s_mul_i32 s46, s46, 30
    s_or_b32 exec_hi, s46, 0x0f0f0f0f
    buffer_store_dwordx4 v[96:99], v118, s[12:15], s83 offen sc1
    s_mov_b64 exec, -1
    s_waitcnt lgkmcnt(0)
    v_readfirstlane_b32 s77, v104
    v_mov_b32 v100, s16
    s_cmp_gt_u32 s77, 20
    s_cbranch_scc1 K_OVFOUT
K_OVFBACK:
    s_cmp_lg_u32 s64, 0
    s_cbranch_scc1 K_NODIR
    s_lshl_b32 s75, s2, 5
    s_add_u32 s75, s75, 8388608
    s_mov_b64 exec, 3
    buffer_store_dwordx4 v[100:103], v75, s[24:27], s75 offen sc1
    s_mov_b64 exec, -1
K_NODIR:
    s_add_u32 s74, s78, 13312
    s_mov_b64 s[60:61], s[84:85]
    s_mov_b64 s[62:63], s[86:87]
    v_mov_b32 v73, v85
    v_mov_b32 v118, v87
    v_mov_b32 v119, v78
    v_mov_b32 v122, v126
    s_mov_b64 s[40:41], -1
    s_mov_b64 s[42:43], -1
    s_mov_b64 s[44:45], s[62:63]
    s_mov_b32 s83, 0x07030703
    s_mov_b32 s66, 0x05040100
    s_mov_b32 s75, 0x40000
    v_mov_b32 v121, 208
    s_waitcnt vmcnt(3)
    s_cmp_ge_u32 s64, 4
    s_cbranch_scc1 K_NOCV
    s_cmp_lt_u32 s64, 2
    s_cselect_b32 s46, 1, 4
    s_cselect_b64 vcc, -1, 0
    s_lshl_b32 s46, s46, 9
    s_and_b32 s47, s64, 1
    s_lshl_b32 s48, s47, 12
    v_cndmask_b32 v124, v125, v124, vcc
    v_add_u32 v124, s48, v124
    v_add_u32 v125, s46, v124
    ds_read_b64_tr_b16 v[24:25], v124 offset:0
    ds_read_b64_tr_b16 v[26:27], v125 offset:0
    ds_read_b64_tr_b16 v[28:29], v124 offset:8
    ds_read_b64_tr_b16 v[30:31], v125 offset:8
    ds_read_b64_tr_b16 v[32:33], v124 offset:16
    ds_read_b64_tr_b16 v[34:35], v125 offset:16
    ds_read_b64_tr_b16 v[36:37], v124 offset:24
    ds_read_b64_tr_b16 v[38:39], v125 offset:24
    s_lshr_b32 s48, s64, 1
    s_lshl_b32 s48, s48, 3
    s_add_u32 s48, s48, s47
    s_lshl_b32 s48, s48, 10
    s_add_u32 s48, s48, 99488
    v_add_u32 v124, s48, v75
    s_waitcnt lgkmcnt(6)
    ds_write_b128 v124, v[24:27] offset:0
    s_waitcnt lgkmcnt(5)
    ds_write_b128 v124, v[28:31] offset:2048
    s_waitcnt lgkmcnt(4)
    ds_write_b128 v124, v[32:35] offset:4096
    s_waitcnt lgkmcnt(3)
    ds_write_b128 v124, v[36:39] offset:6144
    s_waitcnt lgkmcnt(0)
K_NOCV:
    v_add_u32 v124, 99488, v75
    s_barrier
    s_mov_b64 exec, s[40:41]
    s_cbranch_execz K_PLa0
    buffer_load_dwordx4 v[88:91], v72, s[24:27], s78 offen sc1
K_PLa0:
    s_mov_b64 exec, s[42:43]
    s_cbranch_execz K_PLa1
    buffer_load_dwordx4 v[92:95], v72, s[24:27], s74 offen sc1
K_PLa1:
    s_mov_b64 exec, s[44:45]
    s_cbranch_execz K_PLa2
    buffer_load_dwordx4 v[96:99], v73, s[24:27], 0 offen sc1
K_PLa2:
    s_mov_b64 exec, -1
    s_lshl_b32 s46, s64, 10
    s_add_u32 s32, s46, 134144
    v_mov_b32 v100, 0
    v_mov_b32 v101, 0
    v_mov_b32 v102, 0
    v_mov_b32 v103, 0
    v_add_u32 v104, s32, v75
    ds_write_b128 v104, v[100:103]
    ds_read_b128 v[56:59], v84
    ds_read_b128 v[60:63], v84 offset:64
    ds_read_b128 v[24:27], v124 offset:0
    ds_read_b128 v[28:31], v124 offset:1024
    ds_read_b128 v[32:35], v124 offset:2048
    ds_read_b128 v[36:39], v124 offset:3072
    ds_read_b128 v[40:43], v124 offset:4096
    ds_read_b128 v[44:47], v124 offset:5120
    ds_read_b128 v[48:51], v124 offset:6144
    ds_read_b128 v[52:55], v124 offset:7168
    s_waitcnt lgkmcnt(0)
    v_mfma_f32_16x16x32_bf16 v[100:103], v[24:27], v[56:59], 0
    v_mfma_f32_16x16x32_bf16 v[104:107], v[32:35], v[56:59], 0
    v_mfma_f32_16x16x32_bf16 v[108:111], v[40:43], v[56:59], 0
    v_mfma_f32_16x16x32_bf16 v[112:115], v[48:51], v[56:59], 0
    v_mfma_f32_16x16x32_bf16 v[100:103], v[28:31], v[60:63], v[100:103]
    v_mfma_f32_16x16x32_bf16 v[104:107], v[36:39], v[60:63], v[104:107]
    v_mfma_f32_16x16x32_bf16 v[108:111], v[44:47], v[60:63], v[108:111]
    v_mfma_f32_16x16x32_bf16 v[112:115], v[52:55], v[60:63], v[112:115]
    s_nop 4
    ds_read_b128 v[24:27], v124 offset:8192
    ds_read_b128 v[28:31], v124 offset:9216
    ds_read_b128 v[32:35], v124 offset:10240
    ds_read_b128 v[36:39], v124 offset:11264
    ds_read_b128 v[40:43], v124 offset:12288
    ds_read_b128 v[44:47], v124 offset:13312
    ds_read_b128 v[48:51], v124 offset:14336
    ds_read_b128 v[52:55], v124 offset:15360
    v_cvt_pk_bf16_f32 v16, v100, v101
    v_cvt_pk_bf16_f32 v17, v102, v103
    v_cvt_pk_bf16_f32 v18, v104, v105
    v_cvt_pk_bf16_f32 v19, v106, v107
    v_cvt_pk_bf16_f32 v20, v108, v109
    v_cvt_pk_bf16_f32 v21, v110, v111
    v_cvt_pk_bf16_f32 v22, v112, v113
    v_cvt_pk_bf16_f32 v23, v114, v115
    v_mov_b32 v56, 0
    v_mov_b32 v57, 0
    v_mov_b32 v58, 0
    v_mov_b32 v59, 0
    v_mov_b32 v60, 0
    v_mov_b32 v61, 0
    v_mov_b32 v62, 0
    v_mov_b32 v63, 0
    v_mov_b32 v64, 0
    v_mov_b32 v65, 0
    v_mov_b32 v66, 0
    v_mov_b32 v67, 0
    v_mov_b32 v68, 0
    v_mov_b32 v69, 0
    v_mov_b32 v70, 0
    v_mov_b32 v71, 0
    s_waitcnt lgkmcnt(0)
    s_branch K_CHK
K_POLL:
    s_mov_b64 exec, s[40:41]
    s_cbranch_execz K_PLb0
    buffer_load_dwordx4 v[88:91], v72, s[24:27], s78 offen sc1
K_PLb0:
    s_mov_b64 exec, s[42:43]
    s_cbranch_execz K_PLb1
    buffer_load_dwordx4 v[92:95], v72, s[24:27], s74 offen sc1
K_PLb1:
    s_mov_b64 exec, s[44:45]
    s_cbranch_execz K_PLb2
    buffer_load_dwordx4 v[96:99], v73, s[24:27], 0 offen sc1
K_PLb2:
    s_mov_b64 exec, -1
K_CHK:
    s_waitcnt vmcnt(0)
    v_perm_b32 v100, v89, v88, s83
    v_perm_b32 v101, v91, v90, s83
    v_cmp_lt_u32_sdwa s[48:49], v91, v121 src0_sel:BYTE_2 src1_sel:DWORD
    v_perm_b32 v100, v101, v100, s66
    v_perm_b32 v102, v93, v92, s83
    v_perm_b32 v103, v95, v94, s83
    v_cmp_lt_u32_sdwa s[50:51], v95, v121 src0_sel:BYTE_2 src1_sel:DWORD
    v_perm_b32 v102, v103, v102, s66
    v_perm_b32 v104, v97, v96, s83
    v_perm_b32 v105, v99, v98, s83
    v_cmp_lt_u32_sdwa s[52:53], v99, v121 src0_sel:BYTE_2 src1_sel:DWORD
    v_perm_b32 v104, v105, v104, s66
    v_cndmask_b32 v104, v96, v104, s[60:61]
    v_cmp_ne_u32 s[84:85], s16, v100
    v_cmp_ne_u32 s[86:87], s16, v102
    v_cmp_ne_u32 s[80:81], s16, v104
    s_or_b64 s[48:49], s[48:49], s[84:85]
    s_and_b32 s46, s48, 0x08080808
    s_mul_i32 s46, s46, 30
    s_or_b32 s48, s46, 0x0f0f0f0f
    s_and_b32 s46, s49, 0x08080808
    s_mul_i32 s46, s46, 30
    s_or_b32 s49, s46, 0x0f0f0f0f
    s_and_b64 s[40:41], s[48:49], s[84:85]
    s_or_b64 s[50:51], s[50:51], s[86:87]
    s_and_b32 s46, s50, 0x08080808
    s_mul_i32 s46, s46, 30
    s_or_b32 s50, s46, 0x0f0f0f0f
    s_and_b32 s46, s51, 0x08080808
    s_mul_i32 s46, s46, 30
    s_or_b32 s51, s46, 0x0f0f0f0f
    s_and_b64 s[42:43], s[50:51], s[86:87]
    s_or_b64 s[52:53], s[52:53], s[80:81]
    s_and_b32 s46, s52, 0x08080808
    s_mul_i32 s46, s46, 30
    s_or_b32 s52, s46, 0x0f0f0f0f
    s_and_b32 s46, s53, 0x08080808
    s_mul_i32 s46, s46, 30
    s_or_b32 s53, s46, 0x0f0f0f0f
    s_orn2_b64 s[52:53], s[52:53], s[60:61]
    s_and_b64 s[52:53], s[52:53], s[62:63]
    s_and_b64 s[44:45], s[52:53], s[80:81]
    s_or_b64 vcc, s[40:41], s[42:43]
    s_or_b64 vcc, vcc, s[44:45]
    s_cbranch_scc0 K_GOT
    s_sleep 3
    s_sub_u32 s75, s75, 1
    s_cbranch_scc0 K_POLL
K_GOT:
    s_and_b64 s[80:81], s[80:81], s[60:61]
    s_andn2_b64 exec, -1, s[60:61]
    s_cbranch_execz K_NODIRL
    v_and_b32 v100, 1, v0
    v_mov_b32 v101, 26832
    v_cmp_eq_u32 vcc, 0, v100
    v_mov_b32 v96, -1
    s_and_b64 vcc, vcc, s[62:63]
    s_and_saveexec_b64 s[46:47], vcc
    s_cbranch_execz K_NOMAX
    ds_max_u32 v101, v97
    v_mov_b32 v97, -1
K_NOMAX:
    s_mov_b64 exec, s[46:47]
    v_cmp_eq_u32_sdwa vcc, v97, v122 src0_sel:BYTE_3 src1_sel:DWORD
    s_and_b64 vcc, vcc, s[62:63]
    v_cndmask_b32 v97, v96, v97, vcc
    v_cmp_eq_u32_sdwa vcc, v98, v122 src0_sel:BYTE_3 src1_sel:DWORD
    s_and_b64 vcc, vcc, s[62:63]
    v_cndmask_b32 v98, v96, v98, vcc
    v_cmp_eq_u32_sdwa vcc, v99, v122 src0_sel:BYTE_3 src1_sel:DWORD
    s_and_b64 vcc, vcc, s[62:63]
    v_cndmask_b32 v99, v96, v99, vcc
K_NODIRL:
    s_mov_b64 exec, -1
    v_mov_b32 v120, 0xf0
    v_mov_b32 v121, 208
    s_mov_b32 s77, 5368
    s_mov_b32 s73, 5
    s_mov_b32 s72, 5
    v_cmp_lt_u32_sdwa s[40:41], v88, v121 src0_sel:BYTE_2 src1_sel:DWORD
    v_mul_u32_u24_sdwa v116, s77, v88 dst_sel:DWORD dst_unused:UNUSED_PAD src0_sel:DWORD src1_sel:WORD_0
    v_and_b32_sdwa v117, v120, v88 dst_sel:DWORD dst_unused:UNUSED_PAD src0_sel:DWORD src1_sel:BYTE_2
    v_lshrrev_b32 v116, 24, v116
    v_and_or_b32 v72, v116, 12, v117
    s_andn2_b64 s[40:41], s[40:41], s[84:85]
    s_mov_b64 exec, s[40:41]
    ds_add_rtn_u32 v104, v72, v123 offset:26624
    s_mov_b64 exec, -1
    v_cmp_lt_u32_sdwa s[42:43], v89, v121 src0_sel:BYTE_2 src1_sel:DWORD
    v_mul_u32_u24_sdwa v116, s77, v89 dst_sel:DWORD dst_unused:UNUSED_PAD src0_sel:DWORD src1_sel:WORD_0
    v_and_b32_sdwa v117, v120, v89 dst_sel:DWORD dst_unused:UNUSED_PAD src0_sel:DWORD src1_sel:BYTE_2
    v_lshrrev_b32 v116, 24, v116
    v_and_or_b32 v73, v116, 12, v117
    s_andn2_b64 s[42:43], s[42:43], s[84:85]
    s_mov_b64 exec, s[42:43]
    ds_add_rtn_u32 v105, v73, v123 offset:26624
    s_mov_b64 exec, -1
    v_cmp_lt_u32_sdwa s[44:45], v90, v121 src0_sel:BYTE_2 src1_sel:DWORD
    v_mul_u32_u24_sdwa v116, s77, v90 dst_sel:DWORD dst_unused:UNUSED_PAD src0_sel:DWORD src1_sel:WORD_0
    v_and_b32_sdwa v117, v120, v90 dst_sel:DWORD dst_unused:UNUSED_PAD src0_sel:DWORD src1_sel:BYTE_2
    v_lshrrev_b32 v116, 24, v116
    v_and_or_b32 v74, v116, 12, v117
    s_andn2_b64 s[44:45], s[44:45], s[84:85]
    s_mov_b64 exec, s[44:45]
    ds_add_rtn_u32 v106, v74, v123 offset:26624
    s_mov_b64 exec, -1
    v_cmp_lt_u32_sdwa s[46:47], v91, v121 src0_sel:BYTE_2 src1_sel:DWORD
    v_mul_u32_u24_sdwa v116, s77, v91 dst_sel:DWORD dst_unused:UNUSED_PAD src0_sel:DWORD src1_sel:WORD_0
    v_and_b32_sdwa v117, v120, v91 dst_sel:DWORD dst_unused:UNUSED_PAD src0_sel:DWORD src1_sel:BYTE_2
    v_lshrrev_b32 v116, 24, v116
    v_and_or_b32 v75, v116, 12, v117
    s_andn2_b64 s[46:47], s[46:47], s[84:85]
    s_mov_b64 exec, s[46:47]
    ds_add_rtn_u32 v107, v75, v123 offset:26624
    s_mov_b64 exec, -1
    v_cmp_lt_u32_sdwa s[48:49], v92, v121 src0_sel:BYTE_2 src1_sel:DWORD
    v_mul_u32_u24_sdwa v116, s77, v92 dst_sel:DWORD dst_unused:UNUSED_PAD src0_sel:DWORD src1_sel:WORD_0
    v_and_b32_sdwa v117, v120, v92 dst_sel:DWORD dst_unused:UNUSED_PAD src0_sel:DWORD src1_sel:BYTE_2
    v_lshrrev_b32 v116, 24, v116
    v_and_or_b32 v76, v116, 12, v117
    s_andn2_b64 s[48:49], s[48:49], s[86:87]
    s_mov_b64 exec, s[48:49]
    ds_add_rtn_u32 v108, v76, v123 offset:26624
    s_mov_b64 exec, -1
    v_cmp_lt_u32_sdwa s[50:51], v93, v121 src0_sel:BYTE_2 src1_sel:DWORD
    v_mul_u32_u24_sdwa v116, s77, v93 dst_sel:DWORD dst_unused:UNUSED_PAD src0_sel:DWORD src1_sel:WORD_0
    v_and_b32_sdwa v117, v120, v93 dst_sel:DWORD dst_unused:UNUSED_PAD src0_sel:DWORD src1_sel:BYTE_2
    v_lshrrev_b32 v116, 24, v116
    v_and_or_b32 v77, v116, 12, v117
    s_andn2_b64 s[50:51], s[50:51], s[86:87]
    s_mov_b64 exec, s[50:51]
    ds_add_rtn_u32 v109, v77, v123 offset:26624
    s_mov_b64 exec, -1
    v_cmp_lt_u32_sdwa s[52:53], v94, v121 src0_sel:BYTE_2 src1_sel:DWORD
    v_mul_u32_u24_sdwa v116, s77, v94 dst_sel:DWORD dst_unused:UNUSED_PAD src0_sel:DWORD src1_sel:WORD_0
    v_and_b32_sdwa v117, v120, v94 dst_sel:DWORD dst_unused:UNUSED_PAD src0_sel:DWORD src1_sel:BYTE_2
    v_lshrrev_b32 v116, 24, v116
    v_and_or_b32 v78, v116, 12, v117
    s_andn2_b64 s[52:53], s[52:53], s[86:87]
    s_mov_b64 exec, s[52:53]
    ds_add_rtn_u32 v110, v78, v123 offset:26624
    s_mov_b64 exec, -1
    v_cmp_lt_u32_sdwa s[54:55], v95, v121 src0_sel:BYTE_2 src1_sel:DWORD
    v_mul_u32_u24_sdwa v116, s77, v95 dst_sel:DWORD dst_unused:UNUSED_PAD src0_sel:DWORD src1_sel:WORD_0
    v_and_b32_sdwa v117, v120, v95 dst_sel:DWORD dst_unused:UNUSED_PAD src0_sel:DWORD src1_sel:BYTE_2
    v_lshrrev_b32 v116, 24, v116
    v_and_or_b32 v79, v116, 12, v117
    s_andn2_b64 s[54:55], s[54:55], s[86:87]
    s_mov_b64 exec, s[54:55]
    ds_add_rtn_u32 v111, v79, v123 offset:26624
    s_mov_b64 exec, -1
    v_cmp_lt_u32_sdwa s[56:57], v96, v121 src0_sel:BYTE_2 src1_sel:DWORD
    v_mul_u32_u24_sdwa v116, s77, v96 dst_sel:DWORD dst_unused:UNUSED_PAD src0_sel:DWORD src1_sel:WORD_0
    v_and_b32_sdwa v117, v120, v96 dst_sel:DWORD dst_unused:UNUSED_PAD src0_sel:DWORD src1_sel:BYTE_2
    v_lshrrev_b32 v116, 24, v116
    v_and_or_b32 v80, v116, 12, v117
    s_andn2_b64 s[56:57], s[56:57], s[80:81]
    s_mov_b64 exec, s[56:57]
    ds_add_rtn_u32 v112, v80, v123 offset:26624
    s_mov_b64 exec, -1
    v_cmp_lt_u32_sdwa s[58:59], v97, v121 src0_sel:BYTE_2 src1_sel:DWORD
    v_mul_u32_u24_sdwa v116, s77, v97 dst_sel:DWORD dst_unused:UNUSED_PAD src0_sel:DWORD src1_sel:WORD_0
    v_and_b32_sdwa v117, v120, v97 dst_sel:DWORD dst_unused:UNUSED_PAD src0_sel:DWORD src1_sel:BYTE_2
    v_lshrrev_b32 v116, 24, v116
    v_and_or_b32 v81, v116, 12, v117
    s_andn2_b64 s[58:59], s[58:59], s[80:81]
    s_mov_b64 exec, s[58:59]
    ds_add_rtn_u32 v113, v81, v123 offset:26624
    s_mov_b64 exec, -1
    v_cmp_lt_u32_sdwa s[60:61], v98, v121 src0_sel:BYTE_2 src1_sel:DWORD
    v_mul_u32_u24_sdwa v116, s77, v98 dst_sel:DWORD dst_unused:UNUSED_PAD src0_sel:DWORD src1_sel:WORD_0
    v_and_b32_sdwa v117, v120, v98 dst_sel:DWORD dst_unused:UNUSED_PAD src0_sel:DWORD src1_sel:BYTE_2
    v_lshrrev_b32 v116, 24, v116
    v_and_or_b32 v82, v116, 12, v117
    s_andn2_b64 s[60:61], s[60:61], s[80:81]
    s_mov_b64 exec, s[60:61]
    ds_add_rtn_u32 v114, v82, v123 offset:26624
    s_mov_b64 exec, -1
    v_cmp_lt_u32_sdwa s[62:63], v99, v121 src0_sel:BYTE_2 src1_sel:DWORD
    v_mul_u32_u24_sdwa v116, s77, v99 dst_sel:DWORD dst_unused:UNUSED_PAD src0_sel:DWORD src1_sel:WORD_0
    v_and_b32_sdwa v117, v120, v99 dst_sel:DWORD dst_unused:UNUSED_PAD src0_sel:DWORD src1_sel:BYTE_2
    v_lshrrev_b32 v116, 24, v116
    v_and_or_b32 v83, v116, 12, v117
    s_andn2_b64 s[62:63], s[62:63], s[80:81]
    s_mov_b64 exec, s[62:63]
    ds_add_rtn_u32 v115, v83, v123 offset:26624
    s_mov_b64 exec, -1
    s_waitcnt lgkmcnt(0)
    s_mov_b64 exec, s[40:41]
    v_lshl_add_u32 v72, v72, 7, v104
    v_cmpx_gt_u32 vcc, s76, v104
    ds_write_b32 v72, v88
    s_mov_b64 exec, s[42:43]
    v_lshl_add_u32 v73, v73, 7, v105
    v_cmpx_gt_u32 vcc, s76, v105
    ds_write_b32 v73, v89
    s_mov_b64 exec, s[44:45]
    v_lshl_add_u32 v74, v74, 7, v106
    v_cmpx_gt_u32 vcc, s76, v106
    ds_write_b32 v74, v90
    s_mov_b64 exec, s[46:47]
    v_lshl_add_u32 v75, v75, 7, v107
    v_cmpx_gt_u32 vcc, s76, v107
    ds_write_b32 v75, v91
    s_mov_b64 exec, s[48:49]
    v_lshl_add_u32 v76, v76, 7, v108
    v_cmpx_gt_u32 vcc, s76, v108
    ds_write_b32 v76, v92
    s_mov_b64 exec, s[50:51]
    v_lshl_add_u32 v77, v77, 7, v109
    v_cmpx_gt_u32 vcc, s76, v109
    ds_write_b32 v77, v93
    s_mov_b64 exec, s[52:53]
    v_lshl_add_u32 v78, v78, 7, v110
    v_cmpx_gt_u32 vcc, s76, v110
    ds_write_b32 v78, v94
    s_mov_b64 exec, s[54:55]
    v_lshl_add_u32 v79, v79, 7, v111
    v_cmpx_gt_u32 vcc, s76, v111
    ds_write_b32 v79, v95
    s_mov_b64 exec, s[56:57]
    v_lshl_add_u32 v80, v80, 7, v112
    v_cmpx_gt_u32 vcc, s76, v112
    ds_write_b32 v80, v96
    s_mov_b64 exec, s[58:59]
    v_lshl_add_u32 v81, v81, 7, v113
    v_cmpx_gt_u32 vcc, s76, v113
    ds_write_b32 v81, v97
    s_mov_b64 exec, s[60:61]
    v_lshl_add_u32 v82, v82, 7, v114
    v_cmpx_gt_u32 vcc, s76, v114
    ds_write_b32 v82, v98
    s_mov_b64 exec, s[62:63]
    v_lshl_add_u32 v83, v83, 7, v115
    v_cmpx_gt_u32 vcc, s76, v115
    ds_write_b32 v83, v99
    s_mov_b64 exec, -1
K_CNT:
    s_waitcnt lgkmcnt(0)
    s_barrier
    ds_read_b128 v[100:103], v118 offset:26624
    ds_read2st64_b32 v[104:105], v119 offset0:2 offset1:3
    ds_read2st64_b32 v[106:107], v119 offset0:4 offset1:5
    ds_read2st64_b32 v[108:109], v119 offset0:6 offset1:7
    s_waitcnt lgkmcnt(3)
    v_add3_u32 v110, v100, v101, v102
    v_max3_u32 v111, v100, v101, v102
    v_add_u32 v110, v110, v103
    v_max_u32 v111, v111, v103
    v_readlane_b32 s75, v100, s64
    v_readlane_b32 s74, v101, s64
    v_readlane_b32 s83, v102, s64
    v_readlane_b32 s66, v110, s64
    v_readlane_b32 s67, v100, 13
    v_cmp_lt_u32 vcc, 1792, v110
    v_cmp_lt_u32 s[80:81], s76, v111
    s_add_u32 s74, s74, s75
    s_add_u32 s83, s83, s74
    v_add_u32 v112, s75, v119
    v_add_u32 v113, s74, v119
    v_add_u32 v114, s83, v119
    v_add_u32 v115, s66, v119
    v_mov_b32 v116, -1
    s_cmp_lg_u32 s19, -2
    s_cbranch_scc1 K_KEEP
    s_cmp_le_u32 s67, 20
    s_cselect_b32 s71, 241, 0
    s_or_b64 vcc, vcc, s[80:81]
    s_and_b32 s75, vcc_lo, 0x1fff
    s_cbranch_scc1 K_ALLSLOW
K_KEEP:
    s_waitcnt lgkmcnt(0)
    ds_write2st64_b32 v112, v104, v105 offset0:0 offset1:1
    ds_write2st64_b32 v113, v106, v107 offset0:0 offset1:1
    ds_write2st64_b32 v114, v108, v109 offset0:0 offset1:1
    ds_write_b32 v115, v116
    s_add_u32 s66, s66, 127
    s_lshr_b32 s66, s66, 7
K_GO:
    ds_read_b128 v[112:115], v8
    ds_read_b128 v[104:107], v8 offset:128
    s_setprio 3
    v_and_b32 v124, 0xf0, v14
    v_bfe_u32 v125, v0, 4, 2
    v_and_b32 v126, 15, v0
    v_lshl_add_u32 v124, v125, 2, v124
    v_lshlrev_b32 v111, 6, v126
    v_lshl_add_u32 v111, v125, 4, v111
    v_add_u32 v111, s32, v111
    v_lshrrev_b32 v127, 2, v126
    v_lshrrev_b32 v125, 1, v125
    v_lshl_add_u32 v127, v127, 1, v125
    v_and_b32 v126, 3, v126
    v_lshl_add_u32 v127, v127, 2, v126
    v_lshl_add_u32 v110, v127, 1, s32
    v_add_u32 v125, 1, v124
    v_add_u32 v126, 2, v124
    v_add_u32 v127, 3, v124
    s_mov_b32 s56, 0
    s_mov_b32 s57, -1
    s_cmp_lt_u32 0, s66
    s_cselect_b32 s68, 0, s82
    s_waitcnt lgkmcnt(1)
    s_add_u32 m0, s70, 0
    v_mad_u32_u16 v112, v112, s69, v10
    buffer_load_dwordx4 v112, s[20:23], s68 offen  lds
    s_add_u32 m0, s70, 1024
    v_mad_u32_u16 v113, v113, s69, v11
    buffer_load_dwordx4 v113, s[20:23], s68 offen  lds
    s_add_u32 m0, s70, 2048
    v_mad_u32_u16 v114, v114, s69, v12
    buffer_load_dwordx4 v114, s[20:23], s68 offen  lds
    s_add_u32 m0, s70, 3072
    v_mad_u32_u16 v115, v115, s69, v13
    buffer_load_dwordx4 v115, s[20:23], s68 offen  lds
    s_cmp_lt_u32 1, s66
    s_cselect_b32 s68, 0, s82
    s_waitcnt lgkmcnt(0)
    s_add_u32 m0, s70, 4096
    v_mad_u32_u16 v104, v104, s69, v10
    buffer_load_dwordx4 v104, s[20:23], s68 offen  lds
    s_add_u32 m0, s70, 5120
    v_mad_u32_u16 v105, v105, s69, v11
    buffer_load_dwordx4 v105, s[20:23], s68 offen  lds
    s_add_u32 m0, s70, 6144
    v_mad_u32_u16 v106, v106, s69, v12
    buffer_load_dwordx4 v106, s[20:23], s68 offen  lds
    s_add_u32 m0, s70, 7168
    v_mad_u32_u16 v107, v107, s69, v13
    buffer_load_dwordx4 v107, s[20:23], s68 offen  lds
    v_add_u32 v15, 256, v8
    s_mov_b32 s67, 0
    v_mov_b32 v1, v9
    s_cmp_ge_u32 s67, s66
    s_cbranch_scc1 K_LDONE
K_LOOP:
    s_sub_u32 s58, s66, s67
    s_sub_u32 s59, 3, s67
    s_cmp_lt_u32 s67, 3
    s_cselect_b32 s58, s59, s58
    s_cmp_ge_u32 s58, 4
    s_cbranch_scc1 K_P30
    s_cmp_eq_u32 s58, 3
    s_cbranch_scc1 K_P20
    s_cmp_eq_u32 s58, 2
    s_cbranch_scc1 K_P10
    s_setprio 0
    s_branch K_PD0
K_P30:
    s_setprio 3
    s_branch K_PD0
K_P20:
    s_setprio 2
    s_branch K_PD0
K_P10:
    s_setprio 1
K_PD0:
    s_waitcnt vmcnt(4)
    ds_read_b128 v[72:75], v2 offset:0
    ds_read_b128 v[76:79], v3 offset:0
    ds_read_b128 v[80:83], v2 offset:512
    ds_read_b128 v[84:87], v3 offset:512
    ds_read_b128 v[112:115], v15
    ds_read2_b32 v[104:105], v1 offset0:0 offset1:16
    ds_read_b64_tr_b16 v[88:89], v4 offset:0
    ds_read_b64_tr_b16 v[90:91], v4 offset:512
    ds_read_b64_tr_b16 v[92:93], v5 offset:0
    ds_read_b64_tr_b16 v[94:95], v5 offset:512
    ds_read_b64_tr_b16 v[96:97], v6 offset:0
    ds_read_b64_tr_b16 v[98:99], v6 offset:512
    ds_read_b64_tr_b16 v[100:101], v7 offset:0
    ds_read_b64_tr_b16 v[102:103], v7 offset:512
    s_add_u32 s75, s67, 2
    s_cmp_lt_u32 s75, s66
    s_cselect_b32 s68, 0, s82
    v_add_u32 v15, 128, v15
    v_add_u32 v1, 128, v1
    s_waitcnt lgkmcnt(10)
    v_mfma_f32_16x16x32_bf16 v[116:119], v[16:19], v[72:75], 0
    v_mfma_f32_16x16x32_bf16 v[120:123], v[16:19], v[80:83], 0
    v_mfma_f32_16x16x32_bf16 v[116:119], v[20:23], v[76:79], v[116:119]
    v_mfma_f32_16x16x32_bf16 v[120:123], v[20:23], v[84:87], v[120:123]
    s_waitcnt lgkmcnt(0)
    s_add_u32 m0, s70, 0
    v_mad_u32_u16 v112, v112, s69, v10
    buffer_load_dwordx4 v112, s[20:23], s68 offen  lds
    s_add_u32 m0, s70, 1024
    v_mad_u32_u16 v113, v113, s69, v11
    buffer_load_dwordx4 v113, s[20:23], s68 offen  lds
    s_add_u32 m0, s70, 2048
    v_mad_u32_u16 v114, v114, s69, v12
    buffer_load_dwordx4 v114, s[20:23], s68 offen  lds
    s_add_u32 m0, s70, 3072
    v_mad_u32_u16 v115, v115, s69, v13
    buffer_load_dwordx4 v115, s[20:23], s68 offen  lds
    v_cmp_eq_u32_sdwa s[40:41], v104, v124 src0_sel:BYTE_2 src1_sel:DWORD
    v_cmp_eq_u32_sdwa s[42:43], v104, v125 src0_sel:BYTE_2 src1_sel:DWORD
    v_cmp_eq_u32_sdwa s[44:45], v104, v126 src0_sel:BYTE_2 src1_sel:DWORD
    v_cmp_eq_u32_sdwa s[46:47], v104, v127 src0_sel:BYTE_2 src1_sel:DWORD
    v_cmp_eq_u32_sdwa s[48:49], v105, v124 src0_sel:BYTE_2 src1_sel:DWORD
    v_cmp_eq_u32_sdwa s[50:51], v105, v125 src0_sel:BYTE_2 src1_sel:DWORD
    v_cmp_eq_u32_sdwa s[52:53], v105, v126 src0_sel:BYTE_2 src1_sel:DWORD
    v_cmp_eq_u32_sdwa s[54:55], v105, v127 src0_sel:BYTE_2 src1_sel:DWORD
    v_cndmask_b32 v109, v104, v105, s[56:57]
    v_cndmask_b32 v106, 0, v116, s[40:41]
    v_cndmask_b32 v107, 0, v120, s[48:49]
    v_cndmask_b32 v106, v106, v117, s[42:43]
    v_cndmask_b32 v107, v107, v121, s[50:51]
    v_cndmask_b32 v106, v106, v118, s[44:45]
    v_cndmask_b32 v107, v107, v122, s[52:53]
    v_cndmask_b32 v106, v106, v119, s[46:47]
    v_cndmask_b32 v107, v107, v123, s[54:55]
    v_bfe_u32 v109, v109, 16, 4
    v_lshl_add_u32 v109, v109, 6, v110
    v_permlane32_swap_b32 v106, v107
    v_add_f32 v106, v106, v107
    v_mov_b32 v108, v106
    s_add_u32 s67, s67, 1
    s_cmp_ge_u32 s67, s66
    v_permlane16_swap_b32 v106, v108
    v_add_f32 v106, v106, v108
    v_mul_f32 v106, s79, v106
    v_exp_f32 v106, v106
    s_nop 0
    v_add_f32 v106, 1.0, v106
    v_rcp_f32 v106, v106
    s_nop 0
    v_cvt_pk_bf16_f32 v106, v106, 0
    ds_write_b16 v109, v106
    ds_read_b128 v[72:75], v111
    ds_write_b16_d16_hi v109, v106
    s_waitcnt lgkmcnt(1)
    v_mfma_f32_16x16x32_bf16 v[56:59], v[88:91], v[72:75], v[56:59]
    v_mfma_f32_16x16x32_bf16 v[60:63], v[92:95], v[72:75], v[60:63]
    v_mfma_f32_16x16x32_bf16 v[64:67], v[96:99], v[72:75], v[64:67]
    v_mfma_f32_16x16x32_bf16 v[68:71], v[100:103], v[72:75], v[68:71]
    s_cbranch_scc1 K_LDONE
    s_cmp_lg_u32 s67, 3
    s_cbranch_scc1 K_NB1
    s_barrier
K_NB1:
    s_sub_u32 s58, s66, s67
    s_sub_u32 s59, 3, s67
    s_cmp_lt_u32 s67, 3
    s_cselect_b32 s58, s59, s58
    s_cmp_ge_u32 s58, 4
    s_cbranch_scc1 K_P31
    s_cmp_eq_u32 s58, 3
    s_cbranch_scc1 K_P21
    s_cmp_eq_u32 s58, 2
    s_cbranch_scc1 K_P11
    s_setprio 0
    s_branch K_PD1
K_P31:
    s_setprio 3
    s_branch K_PD1
K_P21:
    s_setprio 2
    s_branch K_PD1
K_P11:
    s_setprio 1
K_PD1:
    s_waitcnt vmcnt(4)
    ds_read_b128 v[72:75], v2 offset:4096
    ds_read_b128 v[76:79], v3 offset:4096
    ds_read_b128 v[80:83], v2 offset:4608
    ds_read_b128 v[84:87], v3 offset:4608
    ds_read_b128 v[112:115], v15
    ds_read2_b32 v[104:105], v1 offset0:0 offset1:16
    ds_read_b64_tr_b16 v[88:89], v4 offset:4096
    ds_read_b64_tr_b16 v[90:91], v4 offset:4608
    ds_read_b64_tr_b16 v[92:93], v5 offset:4096
    ds_read_b64_tr_b16 v[94:95], v5 offset:4608
    ds_read_b64_tr_b16 v[96:97], v6 offset:4096
    ds_read_b64_tr_b16 v[98:99], v6 offset:4608
    ds_read_b64_tr_b16 v[100:101], v7 offset:4096
    ds_read_b64_tr_b16 v[102:103], v7 offset:4608
    s_add_u32 s75, s67, 2
    s_cmp_lt_u32 s75, s66
    s_cselect_b32 s68, 0, s82
    v_add_u32 v15, 128, v15
    v_add_u32 v1, 128, v1
    s_waitcnt lgkmcnt(10)
    v_mfma_f32_16x16x32_bf16 v[116:119], v[16:19], v[72:75], 0
    v_mfma_f32_16x16x32_bf16 v[120:123], v[16:19], v[80:83], 0
    v_mfma_f32_16x16x32_bf16 v[116:119], v[20:23], v[76:79], v[116:119]
    v_mfma_f32_16x16x32_bf16 v[120:123], v[20:23], v[84:87], v[120:123]
    s_waitcnt lgkmcnt(0)
    s_add_u32 m0, s70, 4096
    v_mad_u32_u16 v112, v112, s69, v10
    buffer_load_dwordx4 v112, s[20:23], s68 offen  lds
    s_add_u32 m0, s70, 5120
    v_mad_u32_u16 v113, v113, s69, v11
    buffer_load_dwordx4 v113, s[20:23], s68 offen  lds
    s_add_u32 m0, s70, 6144
    v_mad_u32_u16 v114, v114, s69, v12
    buffer_load_dwordx4 v114, s[20:23], s68 offen  lds
    s_add_u32 m0, s70, 7168
    v_mad_u32_u16 v115, v115, s69, v13
    buffer_load_dwordx4 v115, s[20:23], s68 offen  lds
    v_cmp_eq_u32_sdwa s[40:41], v104, v124 src0_sel:BYTE_2 src1_sel:DWORD
    v_cmp_eq_u32_sdwa s[42:43], v104, v125 src0_sel:BYTE_2 src1_sel:DWORD
    v_cmp_eq_u32_sdwa s[44:45], v104, v126 src0_sel:BYTE_2 src1_sel:DWORD
    v_cmp_eq_u32_sdwa s[46:47], v104, v127 src0_sel:BYTE_2 src1_sel:DWORD
    v_cmp_eq_u32_sdwa s[48:49], v105, v124 src0_sel:BYTE_2 src1_sel:DWORD
    v_cmp_eq_u32_sdwa s[50:51], v105, v125 src0_sel:BYTE_2 src1_sel:DWORD
    v_cmp_eq_u32_sdwa s[52:53], v105, v126 src0_sel:BYTE_2 src1_sel:DWORD
    v_cmp_eq_u32_sdwa s[54:55], v105, v127 src0_sel:BYTE_2 src1_sel:DWORD
    v_cndmask_b32 v109, v104, v105, s[56:57]
    v_cndmask_b32 v106, 0, v116, s[40:41]
    v_cndmask_b32 v107, 0, v120, s[48:49]
    v_cndmask_b32 v106, v106, v117, s[42:43]
    v_cndmask_b32 v107, v107, v121, s[50:51]
    v_cndmask_b32 v106, v106, v118, s[44:45]
    v_cndmask_b32 v107, v107, v122, s[52:53]
    v_cndmask_b32 v106, v106, v119, s[46:47]
    v_cndmask_b32 v107, v107, v123, s[54:55]
    v_bfe_u32 v109, v109, 16, 4
    v_lshl_add_u32 v109, v109, 6, v110
    v_permlane32_swap_b32 v106, v107
    v_add_f32 v106, v106, v107
    v_mov_b32 v108, v106
    s_add_u32 s67, s67, 1
    s_cmp_ge_u32 s67, s66
    v_permlane16_swap_b32 v106, v108
    v_add_f32 v106, v106, v108
    v_mul_f32 v106, s79, v106
    v_exp_f32 v106, v106
    s_nop 0
    v_add_f32 v106, 1.0, v106
    v_rcp_f32 v106, v106
    s_nop 0
    v_cvt_pk_bf16_f32 v106, v106, 0
    ds_write_b16 v109, v106
    ds_read_b128 v[72:75], v111
    ds_write_b16_d16_hi v109, v106
    s_waitcnt lgkmcnt(1)
    v_mfma_f32_16x16x32_bf16 v[56:59], v[88:91], v[72:75], v[56:59]
    v_mfma_f32_16x16x32_bf16 v[60:63], v[92:95], v[72:75], v[60:63]
    v_mfma_f32_16x16x32_bf16 v[64:67], v[96:99], v[72:75], v[64:67]
    v_mfma_f32_16x16x32_bf16 v[68:71], v[100:103], v[72:75], v[68:71]
    s_cbranch_scc0 K_LOOP
K_LDONE:
    s_cmp_gt_u32 s66, 3
    s_cbranch_scc1 K_NB2
    s_barrier
K_NB2:
    s_cmp_lt_i32 s71, 241
    s_cbranch_scc1 K_NEXT
K_FINAL:
    s_nop 7
    v_cvt_pk_bf16_f32 v72, v56, v57
    v_cvt_pk_bf16_f32 v73, v58, v59
    v_cvt_pk_bf16_f32 v74, v60, v61
    v_cvt_pk_bf16_f32 v75, v62, v63
    v_cvt_pk_bf16_f32 v76, v64, v65
    v_cvt_pk_bf16_f32 v77, v66, v67
    v_cvt_pk_bf16_f32 v78, v68, v69
    v_cvt_pk_bf16_f32 v79, v70, v71
    v_lshlrev_b32 v88, 16, v72
    v_and_b32 v89, 0xffff0000, v72
    v_lshlrev_b32 v90, 16, v73
    v_and_b32 v91, 0xffff0000, v73
    v_lshlrev_b32 v92, 16, v74
    v_and_b32 v93, 0xffff0000, v74
    v_lshlrev_b32 v94, 16, v75
    v_and_b32 v95, 0xffff0000, v75
    v_lshlrev_b32 v96, 16, v76
    v_and_b32 v97, 0xffff0000, v76
    v_lshlrev_b32 v98, 16, v77
    v_and_b32 v99, 0xffff0000, v77
    v_lshlrev_b32 v100, 16, v78
    v_and_b32 v101, 0xffff0000, v78
    v_lshlrev_b32 v102, 16, v79
    v_and_b32 v103, 0xffff0000, v79
    v_sub_f32 v88, v56, v88
    v_sub_f32 v89, v57, v89
    v_sub_f32 v90, v58, v90
    v_sub_f32 v91, v59, v91
    v_sub_f32 v92, v60, v92
    v_sub_f32 v93, v61, v93
    v_sub_f32 v94, v62, v94
    v_sub_f32 v95, v63, v95
    v_sub_f32 v96, v64, v96
    v_sub_f32 v97, v65, v97
    v_sub_f32 v98, v66, v98
    v_sub_f32 v99, v67, v99
    v_sub_f32 v100, v68, v100
    v_sub_f32 v101, v69, v101
    v_sub_f32 v102, v70, v102
    v_sub_f32 v103, v71, v103
    v_cvt_pk_bf16_f32 v80, v88, v89
    v_cvt_pk_bf16_f32 v81, v90, v91
    v_cvt_pk_bf16_f32 v82, v92, v93
    v_cvt_pk_bf16_f32 v83, v94, v95
    v_cvt_pk_bf16_f32 v84, v96, v97
    v_cvt_pk_bf16_f32 v85, v98, v99
    v_cvt_pk_bf16_f32 v86, v100, v101
    v_cvt_pk_bf16_f32 v87, v102, v103
    v_lshlrev_b32 v15, 7, v14
    v_and_b32 v2, 48, v0
    v_lshl_add_u32 v15, v2, 1, v15
    s_lshl_b32 s75, s65, 7
    v_mfma_f32_16x16x32_bf16 v[56:59], v[24:27], v[80:83], 0
    v_mfma_f32_16x16x32_bf16 v[60:63], v[32:35], v[80:83], 0
    v_mfma_f32_16x16x32_bf16 v[64:67], v[40:43], v[80:83], 0
    v_mfma_f32_16x16x32_bf16 v[68:71], v[48:51], v[80:83], 0
    v_mfma_f32_16x16x32_bf16 v[56:59], v[28:31], v[84:87], v[56:59]
    v_mfma_f32_16x16x32_bf16 v[60:63], v[36:39], v[84:87], v[60:63]
    v_mfma_f32_16x16x32_bf16 v[64:67], v[44:47], v[84:87], v[64:67]
    v_mfma_f32_16x16x32_bf16 v[68:71], v[52:55], v[84:87], v[68:71]
    v_mfma_f32_16x16x32_bf16 v[56:59], v[24:27], v[72:75], v[56:59]
    v_mfma_f32_16x16x32_bf16 v[60:63], v[32:35], v[72:75], v[60:63]
    v_mfma_f32_16x16x32_bf16 v[64:67], v[40:43], v[72:75], v[64:67]
    v_mfma_f32_16x16x32_bf16 v[68:71], v[48:51], v[72:75], v[68:71]
    v_mfma_f32_16x16x32_bf16 v[56:59], v[28:31], v[76:79], v[56:59]
    v_mfma_f32_16x16x32_bf16 v[60:63], v[36:39], v[76:79], v[60:63]
    v_mfma_f32_16x16x32_bf16 v[64:67], v[44:47], v[76:79], v[64:67]
    v_mfma_f32_16x16x32_bf16 v[68:71], v[52:55], v[76:79], v[68:71]
    s_nop 7
    v_cvt_pk_bf16_f32 v88, v56, v57
    v_cvt_pk_bf16_f32 v89, v58, v59
    v_cvt_pk_bf16_f32 v90, v60, v61
    v_cvt_pk_bf16_f32 v91, v62, v63
    v_cvt_pk_bf16_f32 v92, v64, v65
    v_cvt_pk_bf16_f32 v93, v66, v67
    v_cvt_pk_bf16_f32 v94, v68, v69
    v_cvt_pk_bf16_f32 v95, v70, v71
    s_waitcnt vmcnt(0)
    buffer_store_dwordx4 v[88:91], v15, s[36:39], s75 offen nt
    buffer_store_dwordx4 v[92:95], v15, s[36:39], s75 offen offset:16 nt
    s_cmp_lg_u32 s2, 0
    s_cbranch_scc1 K_NOEP
    s_cmp_lg_u32 s64, 12
    s_cbranch_scc1 K_NOEP
    v_mov_b32 v110, s3
    v_mov_b32 v111, 15728640
    buffer_store_dword v110, v111, s[24:27], 0 offen sc1
K_NOEP:
K_END:
    s_endpgm
K_OVF:
    v_cmp_le_u32 vcc, 128, v104
    s_and_saveexec_b64 s[62:63], vcc
    s_cbranch_execz K_OV0
    ds_add_rtn_u32 v109, v116, v123 offset:4
    s_waitcnt lgkmcnt(0)
    v_cmp_le_u32 vcc, 8, v109
    v_add_u32 v110, 4, v109
    s_nop 0
    v_cndmask_b32 v109, v109, v110, vcc
    ds_write_b32 v109, v88 offset:59528
K_OV0:
    s_mov_b64 exec, s[62:63]
    v_cmp_le_u32 vcc, 128, v105
    s_and_saveexec_b64 s[62:63], vcc
    s_cbranch_execz K_OV1
    ds_add_rtn_u32 v109, v116, v123 offset:4
    s_waitcnt lgkmcnt(0)
    v_cmp_le_u32 vcc, 8, v109
    v_add_u32 v110, 4, v109
    s_nop 0
    v_cndmask_b32 v109, v109, v110, vcc
    ds_write_b32 v109, v89 offset:59528
K_OV1:
    s_mov_b64 exec, s[62:63]
    v_cmp_le_u32 vcc, 128, v106
    s_and_saveexec_b64 s[62:63], vcc
    s_cbranch_execz K_OV2
    ds_add_rtn_u32 v109, v116, v123 offset:4
    s_waitcnt lgkmcnt(0)
    v_cmp_le_u32 vcc, 8, v109
    v_add_u32 v110, 4, v109
    s_nop 0
    v_cndmask_b32 v109, v109, v110, vcc
    ds_write_b32 v109, v90 offset:59528
K_OV2:
    s_mov_b64 exec, s[62:63]
    v_cmp_le_u32 vcc, 128, v107
    s_and_saveexec_b64 s[62:63], vcc
    s_cbranch_execz K_OV3
    ds_add_rtn_u32 v109, v116, v123 offset:4
    s_waitcnt lgkmcnt(0)
    v_cmp_le_u32 vcc, 8, v109
    v_add_u32 v110, 4, v109
    s_nop 0
    v_cndmask_b32 v109, v109, v110, vcc
    ds_write_b32 v109, v91 offset:59528
K_OV3:
    s_mov_b64 exec, s[62:63]
    s_branch K_BINDONE
K_OVFOUT:
    ds_read_b128 v[104:107], v72 offset:59520
    s_mul_i32 s75, s2, 13344
    s_add_u32 s75, s75, 9437184
    s_waitcnt lgkmcnt(0)
    buffer_store_dwordx4 v[104:107], v72, s[24:27], s75 offen sc1
    s_cmp_lg_u32 s64, 0
    s_cbranch_scc1 K_OVFO2
    v_add_u32 v108, 72832, v72
    ds_read_b128 v[104:107], v108
    s_add_u32 s75, s75, 13312
    s_waitcnt lgkmcnt(0)
    s_mov_b64 exec, 3
    buffer_store_dwordx4 v[104:107], v72, s[24:27], s75 offen sc1
    s_mov_b64 exec, -1
K_OVFO2:
    s_waitcnt vmcnt(0)
    s_barrier
    s_branch K_OVFBACK
K_ALLSLOW:
    s_mov_b32 s73, 0
    s_mov_b32 s71, -1
    s_mov_b32 s72, 0
    s_mov_b32 s66, 0
    s_waitcnt lgkmcnt(0)
    s_branch K_GO
K_NEXT:
    s_mov_b32 s19, 0
    s_cmp_lg_i32 s71, -1
    s_cbranch_scc1 K_NSEG
    s_cmp_lt_u32 s72, 7712
    s_cbranch_scc0 K_TOSEG
    s_mul_i32 s78, s2, 30848
    s_mov_b32 s77, 7712
    s_branch K_DO
K_TOSEG:
    s_mov_b32 s71, 0
    s_mov_b32 s72, s73
K_NSEG:
    s_cmp_ge_i32 s71, 241
    s_cbranch_scc1 K_FINAL
    s_lshl_b32 s75, s71, 5
    s_add_u32 s75, s75, 8388612
    v_mov_b32 v72, 0
    buffer_load_dword v73, v72, s[24:27], s75 offen sc1
    s_waitcnt vmcnt(0)
    v_readfirstlane_b32 s77, v73
    s_lshr_b32 s77, s77, 2
    s_min_u32 s77, s77, 3328
    s_cmp_lt_u32 s72, s77
    s_cbranch_scc1 K_SEGOK
    s_add_u32 s71, s71, 1
    s_mov_b32 s72, s73
    s_branch K_NSEG
K_SEGOK:
    s_mul_i32 s78, s71, 13344
    s_add_u32 s78, s78, 9437192
    s_cmp_gt_u32 s77, 5
    s_cbranch_scc1 K_DO
    s_lshl_b32 s78, s71, 5
    s_add_u32 s78, s78, 8388616
K_DO:
    s_waitcnt vmcnt(0) lgkmcnt(0)
    s_setprio 0
    s_nop 7
    s_barrier
    v_lshlrev_b32 v72, 4, v0
    v_mov_b32 v104, -1
    v_mov_b32 v105, -1
    v_mov_b32 v106, -1
    v_mov_b32 v107, -1
    v_mov_b32 v108, 0
    v_mov_b32 v109, 0
    v_mov_b32 v110, 0
    v_mov_b32 v111, 0
    ds_write_b128 v72, v[104:107]
    ds_write_b128 v72, v[104:107] offset:13312
    v_and_b32 v73, 0xff, v72
    ds_write_b128 v73, v[108:111] offset:26624
    v_add_u32 v73, s72, v0
    v_cmp_gt_u32 vcc, s77, v73
    v_cmp_gt_u32 s[80:81], s69, v0
    v_mov_b32 v88, -1
    v_mov_b32 v89, -1
    s_and_b64 s[80:81], vcc, s[80:81]
    s_cmp_eq_i32 s71, -1
    s_cbranch_scc1 K_NOSKIP
    v_cmp_le_u32 vcc, 2, v73
    s_nop 1
    v_addc_co_u32 v73, vcc, 0, v73, vcc
K_NOSKIP:
    v_and_b32 v75, 16, v73
    v_or_b32 v74, 15, v73
    v_and_b32 v74, 0xffffffef, v74
    v_lshlrev_b32 v74, 2, v74
    v_lshlrev_b32 v73, 2, v73
    s_mov_b64 exec, s[80:81]
    s_cbranch_execz K_NOLD
    buffer_load_dword v88, v73, s[24:27], s78 offen sc1
    buffer_load_dword v89, v74, s[24:27], s78 offen sc1
K_NOLD:
    s_mov_b64 exec, -1
    s_add_u32 s72, s72, 128
    s_mov_b32 s77, 5368
    v_mov_b32 v122, s2
    v_mov_b32 v123, 4
    v_mov_b32 v120, 0xf0
    v_mov_b32 v121, 208
    v_and_b32 v118, 15, v0
    v_lshlrev_b32 v118, 4, v118
    v_and_b32 v119, 63, v0
    s_lshl_b32 s75, s64, 11
    v_lshl_add_u32 v119, v119, 2, s75
    s_waitcnt vmcnt(0) lgkmcnt(0)
    s_cmp_eq_i32 s71, -1
    v_cmp_lt_u32_sdwa vcc, v89, v121 src0_sel:BYTE_2 src1_sel:DWORD
    v_cmp_eq_u32 s[46:47], 0, v75
    s_cbranch_scc1 K_SLOTCHK
    v_cmp_eq_u32_sdwa vcc, v88, v122 src0_sel:BYTE_3 src1_sel:DWORD
    s_branch K_NOCHK
K_SLOTCHK:
    s_or_b64 vcc, vcc, s[46:47]
K_NOCHK:
    s_nop 1
    v_cndmask_b32 v88, v104, v88, vcc
    s_barrier
    v_cmp_lt_u32_sdwa s[40:41], v88, v121 src0_sel:BYTE_2 src1_sel:DWORD
    v_mul_u32_u24_sdwa v116, s77, v88 dst_sel:DWORD dst_unused:UNUSED_PAD src0_sel:DWORD src1_sel:WORD_0
    v_and_b32_sdwa v117, v120, v88 dst_sel:DWORD dst_unused:UNUSED_PAD src0_sel:DWORD src1_sel:BYTE_2
    v_lshrrev_b32 v116, 24, v116
    v_and_or_b32 v72, v116, 12, v117
    s_mov_b64 exec, s[40:41]
    ds_add_rtn_u32 v104, v72, v123 offset:26624
    s_mov_b64 exec, -1
    s_waitcnt lgkmcnt(0)
    s_mov_b64 exec, s[40:41]
    v_lshl_add_u32 v72, v72, 7, v104
    v_cmpx_gt_u32 vcc, s76, v104
    ds_write_b32 v72, v88
    s_mov_b64 exec, -1
    s_branch K_CNT
.section .rodata,"a"
.p2align 6
.amdhsa_kernel gather_scatter__kernel_systems_refs_featgraph__graph_kernel
  .amdhsa_next_free_vgpr 128
  .amdhsa_next_free_sgpr 88
  .amdhsa_accum_offset 128
  .amdhsa_group_segment_fixed_size 0
  .amdhsa_kernarg_size 64
  .amdhsa_user_sgpr_count 2
  .amdhsa_user_sgpr_kernarg_segment_ptr 1
  .amdhsa_system_sgpr_workgroup_id_x 1
.end_amdhsa_kernel
```
